```python
import torch

def _softmax(x, axis=-1):
    return torch.softmax(x, dim=axis)
def _gelu(x):
    return torch.nn.functional.gelu(x, approximate="tanh")
def _silu(x):
    return torch.nn.functional.silu(x)
def _sigmoid(x):
    return torch.sigmoid(x)
def _layernorm(x, axis=-1, eps=1e-5):
    m = x.mean(dim=axis, keepdim=True)
    v = x.var(dim=axis, keepdim=True, unbiased=False)
    return (x - m) / torch.sqrt(v + eps)
def _scatter_add(tgt, idx, src, axis=0):
    return tgt.clone().index_add_(axis, idx, src)
def _segment_sum(src, seg, n):
    out = torch.zeros((n,) + src.shape[1:], dtype=src.dtype)
    return out.index_add_(0, seg, src)
def _pad(x, pw):
    flat = tuple(v for pair in reversed(pw) for v in pair)
    return torch.nn.functional.pad(x, flat)

kernel_name = 'standalone__channel_attn_cbam__vision'

def setup_inputs():

    _w = (lambda a: (lambda t: t.to(torch.bfloat16) if t.is_floating_point() else t)(torch.as_tensor(a)))
    H = W = 256
    C = 384
    r = max(C // 4, 1)
    return {
        "x": _w((lambda *s: torch.randn(*s, dtype=torch.bfloat16) * 0.1)(1, H, W, C) + (lambda *s: torch.randn(*s, dtype=torch.bfloat16) * 0.1)(1, 1, 1, C) * 2.0),
        "w1": _w((lambda *s: torch.randn(*s, dtype=torch.bfloat16) * 0.1)(C, r)),
        "w2": _w((lambda *s: torch.randn(*s, dtype=torch.bfloat16) * 0.1)(r, C)),
    }

def reference(x, w1, w2):
    B, H, W, C = x.shape
    xf = x.reshape(B, H * W, C)
    gap = torch.mean(xf, 1)
    gmp = torch.amax(xf, 1)
    h_a = gap @ w1
    h_a = h_a * (lambda x, dt: x.to(dt))(h_a > 0, h_a.dtype)
    h_m = gmp @ w1
    h_m = h_m * (lambda x, dt: x.to(dt))(h_m > 0, h_m.dtype)
    scale = _sigmoid(h_a @ w2 + h_m @ w2)
    return x * scale[:, None, None, :]
```

```asm
; @launch grid=(256,1,1) block=(768,1,1) lds=52864
.amdgcn_target "amdgcn-amd-amdhsa--gfx950"
.text
.globl standalone__channel_attn_cbam__vision_kernel
.p2align 8
.type standalone__channel_attn_cbam__vision_kernel,@function
standalone__channel_attn_cbam__vision_kernel:
s_load_dwordx2 s[16:17], s[0:1], 0
s_load_dwordx4 s[12:15], s[0:1], 32
s_load_dwordx2 s[32:33], s[0:1], 16
s_load_dwordx2 s[28:29], s[0:1], 8
s_load_dwordx2 s[20:21], s[0:1], 24
s_cmp_ge_u32 s2, 256
s_cbranch_scc1 L_end
v_lshrrev_b32 v2, 6, v0
v_and_b32 v132, 63, v0
v_readfirstlane_b32 s36, v2
v_and_b32 v5, 7, v0
v_bfe_u32 v6, v0, 3, 3
v_mul_u32_u24 v7, 768, v6
v_lshl_add_u32 v1, v5, 4, v7
s_mul_i32 s44, s36, 11
s_lshr_b32 s44, s44, 5
s_mul_i32 s43, s44, 3
s_sub_u32 s43, s36, s43
s_bfe_u32 s45, s2, 0x10003
s_bfe_u32 s56, s2, 0x10002
s_lshr_b32 s61, s2, 4
s_and_b32 s41, s2, 3
s_lshl_b32 s41, s41, 4
s_add_u32 s61, s61, s41
s_lshl_b32 s62, s61, 2
s_add_u32 s62, s62, s44
s_mul_i32 s62, s62, 196608
s_mul_i32 s58, s45, 3
s_add_u32 s58, s58, s43
s_lshl_b32 s41, s58, 7
s_add_u32 s62, s62, s41
s_mul_i32 s41, s56, 98304
s_add_u32 s39, s62, s41
s_mov_b32 s37, s39
s_movk_i32 s54, 6144
s_mov_b32 s18, 50331648
s_mov_b32 s19, 0x20000
v_mov_b32 v136, 0
v_lshlrev_b32 v4, 2, v132
ds_write_b32 v4, v136 offset:52608
s_cmp_ge_u32 s36, 4
s_waitcnt lgkmcnt(0)
s_cbranch_scc1 L_young
L_go:
buffer_load_dwordx4 v[8:11], v1, s[16:19], s37 offen nt
s_addk_i32 s37, 6144
buffer_load_dwordx4 v[12:15], v1, s[16:19], s37 offen nt
s_addk_i32 s37, 6144
buffer_load_dwordx4 v[16:19], v1, s[16:19], s37 offen nt
s_addk_i32 s37, 6144
buffer_load_dwordx4 v[20:23], v1, s[16:19], s37 offen nt
s_addk_i32 s37, 6144
buffer_load_dwordx4 v[24:27], v1, s[16:19], s37 offen nt
s_addk_i32 s37, 6144
buffer_load_dwordx4 v[28:31], v1, s[16:19], s37 offen nt
s_addk_i32 s37, 6144
buffer_load_dwordx4 v[32:35], v1, s[16:19], s37 offen nt
s_addk_i32 s37, 6144
buffer_load_dwordx4 v[36:39], v1, s[16:19], s37 offen nt
s_addk_i32 s37, 6144
s_cmp_ge_u32 s36, 4
s_cbranch_scc1 L_nb0
s_barrier
L_nb0:
buffer_load_dwordx4 v[40:43], v1, s[16:19], s37 offen nt
s_addk_i32 s37, 6144
buffer_load_dwordx4 v[44:47], v1, s[16:19], s37 offen nt
s_addk_i32 s37, 6144
buffer_load_dwordx4 v[48:51], v1, s[16:19], s37 offen nt
s_addk_i32 s37, 6144
buffer_load_dwordx4 v[52:55], v1, s[16:19], s37 offen nt
s_addk_i32 s37, 6144
buffer_load_dwordx4 v[56:59], v1, s[16:19], s37 offen nt
s_addk_i32 s37, 6144
buffer_load_dwordx4 v[60:63], v1, s[16:19], s37 offen nt
s_addk_i32 s37, 6144
buffer_load_dwordx4 v[64:67], v1, s[16:19], s37 offen nt
s_addk_i32 s37, 6144
buffer_load_dwordx4 v[68:71], v1, s[16:19], s37 offen nt
L_ldone:
v_mov_b32 v144, v1
v_mov_b32 v145, v1
v_mov_b32 v146, v1
v_mov_b32 v147, v1
v_mov_b32 v148, v1
v_mov_b32 v149, v1
v_mov_b32 v150, v1
v_mov_b32 v151, v1
v_mov_b32 v152, v1
v_mov_b32 v153, v1
v_mov_b32 v154, v1
v_mov_b32 v155, v1
v_mov_b32 v156, v1
v_mov_b32 v157, v1
v_mov_b32 v158, v1
v_mov_b32 v159, v1
s_branch L_plainissued
L_young:
s_sub_u32 s40, s20, s16
s_and_b32 s40, s40, 8191
s_sub_u32 s40, s40, 3072
s_cmp_gt_u32 s40, 2048
s_cselect_b32 s57, 0, s36
s_mul_i32 s11, s61, 786432
s_add_u32 s11, s11, 417792
s_add_u32 s11, s11, s20
s_mul_i32 s40, s45, 344064
s_add_u32 s40, s40, s11
s_and_b32 s40, s40, 0xffffc000
s_sub_u32 s40, s40, s20
s_and_b32 s41, s2, 63
s_lshl_b32 s41, s41, 7
s_add_u32 s40, s40, s41
s_add_u32 s50, s20, s40
s_addc_u32 s51, s21, 0
s_cmp_lg_u32 s57, 8
s_cbranch_scc1 L_noprobe
s_load_dword s3, s[50:51], 0 glc
s_load_dword s3, s[50:51], 8192 glc
s_mov_b32 s41, 983040
s_load_dword s3, s[14:15], s41
L_noprobe:
s_lshl_b32 s40, s2, 4
s_add_u32 s40, s40, s36
s_cmp_lg_u32 s40, 4
s_cbranch_scc1 L_b0
s_memrealtime s[4:5]
s_waitcnt lgkmcnt(0)
s_or_b32 s4, s4, 1
s_atomic_swap s4, s[12:13], 0x0
L_b0:
s_barrier
s_cmp_lg_u32 s40, 25
s_cbranch_scc1 L_b0done
s_add_u32 s24, s14, 16383
s_addc_u32 s25, s15, 0
s_and_b32 s24, s24, 0xffffc000
s_mov_b32 s92, 0
s_atomic_swap s92, s[24:25], 798720 glc
s_mov_b32 s93, 0
s_atomic_swap s93, s[24:25], 815104 glc
s_mov_b32 s94, 0
s_atomic_swap s94, s[24:25], 831488 glc
s_mov_b32 s95, 0
s_atomic_swap s95, s[24:25], 847872 glc
s_mov_b32 s96, 0
s_atomic_swap s96, s[24:25], 864256 glc
s_mov_b32 s97, 0
s_atomic_swap s97, s[24:25], 880640 glc
s_mov_b32 s98, 0
s_atomic_swap s98, s[24:25], 897024 glc
s_mov_b32 s99, 0
s_atomic_swap s99, s[24:25], 913408 glc
s_mov_b32 s4, 1
s_waitcnt lgkmcnt(0)
s_atomic_swap s4, s[12:13], 0x80
L_b0done:
s_sub_u32 s60, s2, 2
s_cmp_eq_u32 s36, 9
s_cselect_b32 s60, s60, 64
s_cmp_lt_u32 s60, 16
s_cbranch_scc1 L_vote
L_votedone:
s_cmp_lt_u32 s57, 8
s_cbranch_scc1 L_go
s_add_u32 s40, s20, s62
s_movk_i32 s41, 24576
v_add_u32 v2, s40, v1
v_bfe_u32 v2, v2, 13, 1
v_mad_u32_u24 v72, v2, s41, v1
s_addk_i32 s40, 6144
v_add_u32 v2, s40, v1
v_bfe_u32 v2, v2, 13, 1
v_mad_u32_u24 v73, v2, s41, v1
s_addk_i32 s40, 6144
v_add_u32 v2, s40, v1
v_bfe_u32 v2, v2, 13, 1
v_mad_u32_u24 v74, v2, s41, v1
s_addk_i32 s40, 6144
v_add_u32 v2, s40, v1
v_bfe_u32 v2, v2, 13, 1
v_mad_u32_u24 v75, v2, s41, v1
s_mov_b32 s39, s62
s_mov_b32 s37, s62
s_movk_i32 s54, 30720
v_mov_b32 v7, 52640
s_cmp_lg_u32 s57, 8
s_mov_b32 s57, 0
s_cbranch_scc1 L_prefix
s_add_u32 s24, s14, 16383
s_addc_u32 s25, s15, 0
s_and_b32 s24, s24, 0xffffc000
s_waitcnt lgkmcnt(0)
s_memtime s[4:5]
s_load_dword s3, s[50:51], 0 glc
s_waitcnt lgkmcnt(0)
s_memtime s[6:7]
s_load_dword s3, s[50:51], 8192 glc
s_waitcnt lgkmcnt(0)
s_memtime s[8:9]
s_load_dword s52, s[12:13], 0
s_waitcnt lgkmcnt(0)
s_lshl_b32 s40, s6, 1
s_sub_u32 s40, s40, s4
s_sub_u32 s40, s40, s8
s_min_i32 s40, s40, 600
s_max_i32 s40, s40, -600
s_add_u32 s57, s57, s40
s_cmp_lg_u32 s52, 0
s_cbranch_scc1 L_tg1_ok
s_mov_b32 s42, 1000000
v_mov_b32 v160, 0
L_tg1_lp:
global_load_dword v161, v160, s[12:13] offset:0 sc1
s_waitcnt vmcnt(0)
v_readfirstlane_b32 s52, v161
s_sub_u32 s42, s42, 1
s_cbranch_scc1 L_tg1_ok
s_cmp_eq_u32 s52, 0
s_cbranch_scc1 L_tg1_lp
L_tg1_ok:
s_sub_u32 s41, 0, s57
s_cmp_lg_u32 s56, 0
s_cselect_b32 s5, s41, s57
s_mov_b32 s4, s52
s_lshl_b32 s40, s61, 7
s_add_u32 s40, s40, 966656
s_and_b32 s41, s2, 12
s_lshl_b32 s41, s41, 1
s_add_u32 s41, s41, s40
s_atomic_swap_x2 s[4:5], s[24:25], s41
s_mov_b32 s42, 1000000
L_qpoll:
s_load_dwordx8 s[92:99], s[24:25], s40 glc
s_sub_u32 s42, s42, 1
s_cbranch_scc1 L_qdone
s_waitcnt lgkmcnt(0)
s_cmp_lg_u32 s92, s52
s_cbranch_scc1 L_qpoll
s_cmp_lg_u32 s94, s52
s_cbranch_scc1 L_qpoll
s_cmp_lg_u32 s96, s52
s_cbranch_scc1 L_qpoll
s_cmp_lg_u32 s98, s52
s_cbranch_scc1 L_qpoll
L_qdone:
s_waitcnt lgkmcnt(0)
s_add_u32 s4, s93, s95
s_add_u32 s5, s97, s99
s_and_b32 s40, s11, 0x1fffff
s_sub_u32 s40, 2146303, s40
s_lshr_b32 s40, s40, 14
s_mul_i32 s40, s40, 43691
s_lshr_b32 s40, s40, 17
s_cmp_ge_u32 s40, 8
s_cbranch_scc0 L_twopages
s_add_u32 s4, s4, s5
s_mov_b32 s40, 8
L_twopages:
s_bfm_b32 s40, s40, 0
s_not_b32 s41, s40
s_cmp_gt_i32 s4, 0
s_cselect_b32 s40, s40, 0
s_cmp_gt_i32 s5, 0
s_cselect_b32 s41, s41, 0
s_or_b32 s57, s40, s41
s_sub_u32 s40, 0, s56
s_xor_b32 s57, s57, s40
s_bitset1_b32 s57, 16
v_mov_b32 v88, s57
v_mov_b32 v89, s52
ds_write_b64 v7, v[88:89]
L_prefix:
s_mov_b32 s42, 4000000
L_waitw:
ds_read_b96 v[88:90], v7
s_sub_u32 s42, s42, 1
s_cbranch_scc1 L_havew
s_waitcnt lgkmcnt(0)
v_readfirstlane_b32 s57, v88
s_cmp_eq_u32 s57, 0
s_cbranch_scc1 L_waitw
L_havew:
s_lshl_b32 s40, s44, 2
s_sub_u32 s40, s40, 8
s_lshr_b32 s41, s57, s40
s_bitcmp1_b32 s41, 0
s_cselect_b32 s40, 24576, 0
v_xor_b32 v144, s40, v72
buffer_load_dwordx4 v[8:11], v144, s[16:19], s37 offen nt
s_addk_i32 s37, 6144
v_xor_b32 v145, s40, v73
buffer_load_dwordx4 v[12:15], v145, s[16:19], s37 offen nt
s_addk_i32 s37, 6144
v_xor_b32 v146, s40, v74
buffer_load_dwordx4 v[16:19], v146, s[16:19], s37 offen nt
s_addk_i32 s37, 6144
v_xor_b32 v147, s40, v75
buffer_load_dwordx4 v[20:23], v147, s[16:19], s37 offen nt
s_addk_i32 s37, 30720
s_bitcmp1_b32 s41, 1
s_cselect_b32 s40, 24576, 0
v_xor_b32 v148, s40, v72
buffer_load_dwordx4 v[24:27], v148, s[16:19], s37 offen nt
s_addk_i32 s37, 6144
v_xor_b32 v149, s40, v73
buffer_load_dwordx4 v[28:31], v149, s[16:19], s37 offen nt
s_addk_i32 s37, 6144
v_xor_b32 v150, s40, v74
buffer_load_dwordx4 v[32:35], v150, s[16:19], s37 offen nt
s_addk_i32 s37, 6144
v_xor_b32 v151, s40, v75
buffer_load_dwordx4 v[36:39], v151, s[16:19], s37 offen nt
s_addk_i32 s37, 30720
s_bitcmp1_b32 s41, 2
s_cselect_b32 s40, 24576, 0
v_xor_b32 v152, s40, v72
buffer_load_dwordx4 v[40:43], v152, s[16:19], s37 offen nt
s_addk_i32 s37, 6144
v_xor_b32 v153, s40, v73
buffer_load_dwordx4 v[44:47], v153, s[16:19], s37 offen nt
s_addk_i32 s37, 6144
v_xor_b32 v154, s40, v74
buffer_load_dwordx4 v[48:51], v154, s[16:19], s37 offen nt
s_addk_i32 s37, 6144
v_xor_b32 v155, s40, v75
buffer_load_dwordx4 v[52:55], v155, s[16:19], s37 offen nt
s_addk_i32 s37, 30720
s_bitcmp1_b32 s41, 3
s_cselect_b32 s40, 24576, 0
v_xor_b32 v156, s40, v72
buffer_load_dwordx4 v[56:59], v156, s[16:19], s37 offen nt
s_addk_i32 s37, 6144
v_xor_b32 v157, s40, v73
buffer_load_dwordx4 v[60:63], v157, s[16:19], s37 offen nt
s_addk_i32 s37, 6144
v_xor_b32 v158, s40, v74
buffer_load_dwordx4 v[64:67], v158, s[16:19], s37 offen nt
s_addk_i32 s37, 6144
v_xor_b32 v159, s40, v75
buffer_load_dwordx4 v[68:71], v159, s[16:19], s37 offen nt
s_branch L_issued
L_plainissued:
s_cmp_lg_u32 s36, 8
s_cbranch_scc1 L_issued
s_load_dword s52, s[12:13], 0
v_mov_b32 v2, 52644
s_waitcnt lgkmcnt(0)
v_mov_b32 v3, s52
ds_write_b32 v2, v3
L_issued:
s_lshl_b32 s61, s61, 1
s_add_u32 s61, s61, s56
s_add_u32 s24, s14, 16383
s_addc_u32 s25, s15, 0
s_and_b32 s24, s24, 0xffffc000
s_mov_b32 s26, 1015808
s_mov_b32 s27, 0x20000
s_mov_b32 s34, 73728
s_mov_b32 s35, 0x20000
s_mov_b32 s30, 73728
s_mov_b32 s31, 0x20000
s_mov_b32 s22, 50331648
s_mov_b32 s23, 0x20000
s_getreg_b32 s63, hwreg(HW_REG_XCC_ID)
s_and_b32 s63, s63, 7
s_lshl_b32 s100, s63, 14
s_add_u32 s100, s100, 786432
s_mov_b32 s101, 0
s_mov_b32 s38, 0xffff0000
s_mov_b32 s55, 0x07060302
s_lshl_b32 s40, s58, 17
s_lshr_b32 s41, s61, 5
s_lshl_b32 s41, s41, 14
s_add_u32 s40, s40, s41
s_and_b32 s61, s61, 31
s_lshl_b32 s61, s61, 8
s_add_u32 s61, s61, s40
s_mov_b32 s46, 0
s_mov_b32 s47, -1
s_mov_b32 s48, 0xffff0000
s_mov_b32 s49, 0xffff0000
v_lshlrev_b32 v139, 4, v132
v_lshrrev_b32 v6, 4, v132
v_lshl_add_u32 v133, v5, 2, v6
s_mul_i32 s40, s44, 1536
s_lshl_b32 s41, s43, 9
s_add_u32 s40, s40, s41
s_add_u32 s40, s40, 43008
v_lshl_add_u32 v133, v133, 4, s40
v_and_b32 v134, 0x1f0, v139
s_add_u32 s41, s41, 43008
v_add_u32 v134, s41, v134
s_lshl_b32 s40, s43, 8
s_add_u32 s40, s40, 51840
v_lshl_add_u32 v135, v5, 5, s40
v_and_b32 v7, 1, v132
v_mul_u32_u24 v7, 192, v7
v_lshl_add_u32 v137, v6, 4, v7
v_and_b32 v7, 15, v132
s_lshl_b32 s40, s36, 6
s_add_u32 s40, s40, 51840
v_lshl_add_u32 v138, v7, 2, s40
v_and_b32 v2, 1, v6
v_lshlrev_b32 v2, 16, v2
v_lshl_add_u32 v140, v7, 4, v2
v_lshrrev_b32 v2, 1, v6
v_lshl_add_u32 v140, v2, 13, v140
s_lshl_b32 s40, s43, 2
s_add_u32 s40, s40, 52608
v_mov_b32 v4, s40
v_mov_b32 v5, 1
s_and_b32 s41, s36, 1
s_lshl_b32 s41, s41, 2
v_add_u32 v2, 0, v132
v_mul_u32_u24 v7, 2731, v2
v_lshrrev_b32 v7, 16, v7
v_and_b32 v3, 2, v7
v_xor_b32 v2, v2, v3
v_xor_b32 v2, s41, v2
v_mul_u32_u24 v7, 384, v7
v_lshl_add_u32 v120, v2, 4, v7
v_add_u32 v2, 64, v132
v_mul_u32_u24 v7, 2731, v2
v_lshrrev_b32 v7, 16, v7
v_and_b32 v3, 2, v7
v_xor_b32 v2, v2, v3
v_xor_b32 v2, s41, v2
v_mul_u32_u24 v7, 384, v7
v_lshl_add_u32 v121, v2, 4, v7
v_add_u32 v2, 128, v132
v_mul_u32_u24 v7, 2731, v2
v_lshrrev_b32 v7, 16, v7
v_and_b32 v3, 2, v7
v_xor_b32 v2, v2, v3
v_xor_b32 v2, s41, v2
v_mul_u32_u24 v7, 384, v7
v_lshl_add_u32 v122, v2, 4, v7
s_mul_i32 s58, s36, 3072
s_mul_i32 s59, s36, 6144
s_mul_i32 s40, s45, 384
s_add_u32 s59, s59, s40
s_add_u32 m0, s58, 0
s_waitcnt vmcnt(14)
v_lshlrev_b32 v88, 16, v8
v_and_b32 v89, s38, v8
v_lshlrev_b32 v90, 16, v12
v_and_b32 v91, s38, v12
v_pk_add_f32 v[72:73], v[88:89], v[90:91]
v_max_f32 v80, v88, v90
v_max_f32 v81, v89, v91
v_lshlrev_b32 v92, 16, v9
v_and_b32 v93, s38, v9
v_lshlrev_b32 v94, 16, v13
v_and_b32 v95, s38, v13
v_pk_add_f32 v[74:75], v[92:93], v[94:95]
v_max_f32 v82, v92, v94
v_max_f32 v83, v93, v95
v_lshlrev_b32 v88, 16, v10
v_and_b32 v89, s38, v10
v_lshlrev_b32 v90, 16, v14
v_and_b32 v91, s38, v14
v_pk_add_f32 v[76:77], v[88:89], v[90:91]
v_max_f32 v84, v88, v90
v_max_f32 v85, v89, v91
v_lshlrev_b32 v92, 16, v11
v_and_b32 v93, s38, v11
v_lshlrev_b32 v94, 16, v15
v_and_b32 v95, s38, v15
v_pk_add_f32 v[78:79], v[92:93], v[94:95]
v_max_f32 v86, v92, v94
v_max_f32 v87, v93, v95
s_waitcnt vmcnt(12)
v_lshlrev_b32 v88, 16, v16
v_and_b32 v89, s38, v16
v_lshlrev_b32 v90, 16, v20
v_and_b32 v91, s38, v20
v_pk_add_f32 v[72:73], v[72:73], v[88:89]
v_max3_f32 v80, v80, v88, v90
v_pk_add_f32 v[72:73], v[72:73], v[90:91]
v_max3_f32 v81, v81, v89, v91
v_lshlrev_b32 v92, 16, v17
v_and_b32 v93, s38, v17
v_lshlrev_b32 v94, 16, v21
v_and_b32 v95, s38, v21
v_pk_add_f32 v[74:75], v[74:75], v[92:93]
v_max3_f32 v82, v82, v92, v94
v_pk_add_f32 v[74:75], v[74:75], v[94:95]
v_max3_f32 v83, v83, v93, v95
v_lshlrev_b32 v88, 16, v18
v_and_b32 v89, s38, v18
v_lshlrev_b32 v90, 16, v22
v_and_b32 v91, s38, v22
v_pk_add_f32 v[76:77], v[76:77], v[88:89]
v_max3_f32 v84, v84, v88, v90
v_pk_add_f32 v[76:77], v[76:77], v[90:91]
v_max3_f32 v85, v85, v89, v91
v_lshlrev_b32 v92, 16, v19
v_and_b32 v93, s38, v19
v_lshlrev_b32 v94, 16, v23
v_and_b32 v95, s38, v23
v_pk_add_f32 v[78:79], v[78:79], v[92:93]
v_max3_f32 v86, v86, v92, v94
v_pk_add_f32 v[78:79], v[78:79], v[94:95]
v_max3_f32 v87, v87, v93, v95
s_waitcnt vmcnt(10)
v_lshlrev_b32 v88, 16, v24
v_and_b32 v89, s38, v24
v_lshlrev_b32 v90, 16, v28
v_and_b32 v91, s38, v28
v_pk_add_f32 v[72:73], v[72:73], v[88:89]
v_max3_f32 v80, v80, v88, v90
v_pk_add_f32 v[72:73], v[72:73], v[90:91]
v_max3_f32 v81, v81, v89, v91
v_lshlrev_b32 v92, 16, v25
v_and_b32 v93, s38, v25
v_lshlrev_b32 v94, 16, v29
v_and_b32 v95, s38, v29
v_pk_add_f32 v[74:75], v[74:75], v[92:93]
v_max3_f32 v82, v82, v92, v94
v_pk_add_f32 v[74:75], v[74:75], v[94:95]
v_max3_f32 v83, v83, v93, v95
v_lshlrev_b32 v88, 16, v26
v_and_b32 v89, s38, v26
v_lshlrev_b32 v90, 16, v30
v_and_b32 v91, s38, v30
v_pk_add_f32 v[76:77], v[76:77], v[88:89]
v_max3_f32 v84, v84, v88, v90
v_pk_add_f32 v[76:77], v[76:77], v[90:91]
v_max3_f32 v85, v85, v89, v91
v_lshlrev_b32 v92, 16, v27
v_and_b32 v93, s38, v27
v_lshlrev_b32 v94, 16, v31
v_and_b32 v95, s38, v31
v_pk_add_f32 v[78:79], v[78:79], v[92:93]
v_max3_f32 v86, v86, v92, v94
v_pk_add_f32 v[78:79], v[78:79], v[94:95]
v_max3_f32 v87, v87, v93, v95
s_waitcnt vmcnt(8)
v_lshlrev_b32 v88, 16, v32
v_and_b32 v89, s38, v32
v_lshlrev_b32 v90, 16, v36
v_and_b32 v91, s38, v36
v_pk_add_f32 v[72:73], v[72:73], v[88:89]
v_max3_f32 v80, v80, v88, v90
v_pk_add_f32 v[72:73], v[72:73], v[90:91]
v_max3_f32 v81, v81, v89, v91
v_lshlrev_b32 v92, 16, v33
v_and_b32 v93, s38, v33
v_lshlrev_b32 v94, 16, v37
v_and_b32 v95, s38, v37
v_pk_add_f32 v[74:75], v[74:75], v[92:93]
v_max3_f32 v82, v82, v92, v94
v_pk_add_f32 v[74:75], v[74:75], v[94:95]
v_max3_f32 v83, v83, v93, v95
v_lshlrev_b32 v88, 16, v34
v_and_b32 v89, s38, v34
v_lshlrev_b32 v90, 16, v38
v_and_b32 v91, s38, v38
v_pk_add_f32 v[76:77], v[76:77], v[88:89]
v_max3_f32 v84, v84, v88, v90
v_pk_add_f32 v[76:77], v[76:77], v[90:91]
v_max3_f32 v85, v85, v89, v91
v_lshlrev_b32 v92, 16, v35
v_and_b32 v93, s38, v35
v_lshlrev_b32 v94, 16, v39
v_and_b32 v95, s38, v39
v_pk_add_f32 v[78:79], v[78:79], v[92:93]
v_max3_f32 v86, v86, v92, v94
v_pk_add_f32 v[78:79], v[78:79], v[94:95]
v_max3_f32 v87, v87, v93, v95
s_waitcnt vmcnt(6)
v_lshlrev_b32 v88, 16, v40
v_and_b32 v89, s38, v40
v_lshlrev_b32 v90, 16, v44
v_and_b32 v91, s38, v44
v_pk_add_f32 v[72:73], v[72:73], v[88:89]
v_max3_f32 v80, v80, v88, v90
v_pk_add_f32 v[72:73], v[72:73], v[90:91]
v_max3_f32 v81, v81, v89, v91
v_lshlrev_b32 v92, 16, v41
v_and_b32 v93, s38, v41
v_lshlrev_b32 v94, 16, v45
v_and_b32 v95, s38, v45
v_pk_add_f32 v[74:75], v[74:75], v[92:93]
v_max3_f32 v82, v82, v92, v94
v_pk_add_f32 v[74:75], v[74:75], v[94:95]
v_max3_f32 v83, v83, v93, v95
v_lshlrev_b32 v88, 16, v42
v_and_b32 v89, s38, v42
v_lshlrev_b32 v90, 16, v46
v_and_b32 v91, s38, v46
v_pk_add_f32 v[76:77], v[76:77], v[88:89]
v_max3_f32 v84, v84, v88, v90
v_pk_add_f32 v[76:77], v[76:77], v[90:91]
v_max3_f32 v85, v85, v89, v91
v_lshlrev_b32 v92, 16, v43
v_and_b32 v93, s38, v43
v_lshlrev_b32 v94, 16, v47
v_and_b32 v95, s38, v47
v_pk_add_f32 v[78:79], v[78:79], v[92:93]
v_max3_f32 v86, v86, v92, v94
v_pk_add_f32 v[78:79], v[78:79], v[94:95]
v_max3_f32 v87, v87, v93, v95
s_waitcnt vmcnt(4)
v_lshlrev_b32 v88, 16, v48
v_and_b32 v89, s38, v48
v_lshlrev_b32 v90, 16, v52
v_and_b32 v91, s38, v52
v_pk_add_f32 v[72:73], v[72:73], v[88:89]
v_max3_f32 v80, v80, v88, v90
v_pk_add_f32 v[72:73], v[72:73], v[90:91]
v_max3_f32 v81, v81, v89, v91
v_lshlrev_b32 v92, 16, v49
v_and_b32 v93, s38, v49
v_lshlrev_b32 v94, 16, v53
v_and_b32 v95, s38, v53
v_pk_add_f32 v[74:75], v[74:75], v[92:93]
v_max3_f32 v82, v82, v92, v94
v_pk_add_f32 v[74:75], v[74:75], v[94:95]
v_max3_f32 v83, v83, v93, v95
v_lshlrev_b32 v88, 16, v50
v_and_b32 v89, s38, v50
v_lshlrev_b32 v90, 16, v54
v_and_b32 v91, s38, v54
v_pk_add_f32 v[76:77], v[76:77], v[88:89]
v_max3_f32 v84, v84, v88, v90
v_pk_add_f32 v[76:77], v[76:77], v[90:91]
v_max3_f32 v85, v85, v89, v91
v_lshlrev_b32 v92, 16, v51
v_and_b32 v93, s38, v51
v_lshlrev_b32 v94, 16, v55
v_and_b32 v95, s38, v55
v_pk_add_f32 v[78:79], v[78:79], v[92:93]
v_max3_f32 v86, v86, v92, v94
v_pk_add_f32 v[78:79], v[78:79], v[94:95]
v_max3_f32 v87, v87, v93, v95
s_waitcnt vmcnt(2)
v_lshlrev_b32 v88, 16, v56
v_and_b32 v89, s38, v56
v_lshlrev_b32 v90, 16, v60
v_and_b32 v91, s38, v60
v_pk_add_f32 v[72:73], v[72:73], v[88:89]
v_max3_f32 v80, v80, v88, v90
v_pk_add_f32 v[72:73], v[72:73], v[90:91]
v_max3_f32 v81, v81, v89, v91
v_lshlrev_b32 v92, 16, v57
v_and_b32 v93, s38, v57
v_lshlrev_b32 v94, 16, v61
v_and_b32 v95, s38, v61
v_pk_add_f32 v[74:75], v[74:75], v[92:93]
v_max3_f32 v82, v82, v92, v94
v_pk_add_f32 v[74:75], v[74:75], v[94:95]
v_max3_f32 v83, v83, v93, v95
v_lshlrev_b32 v88, 16, v58
v_and_b32 v89, s38, v58
v_lshlrev_b32 v90, 16, v62
v_and_b32 v91, s38, v62
v_pk_add_f32 v[76:77], v[76:77], v[88:89]
v_max3_f32 v84, v84, v88, v90
v_pk_add_f32 v[76:77], v[76:77], v[90:91]
v_max3_f32 v85, v85, v89, v91
v_lshlrev_b32 v92, 16, v59
v_and_b32 v93, s38, v59
v_lshlrev_b32 v94, 16, v63
v_and_b32 v95, s38, v63
v_pk_add_f32 v[78:79], v[78:79], v[92:93]
v_max3_f32 v86, v86, v92, v94
v_pk_add_f32 v[78:79], v[78:79], v[94:95]
v_max3_f32 v87, v87, v93, v95
v_mov_b32 v2, 52644
s_waitcnt vmcnt(1)
ds_read_b32 v136, v2
v_lshlrev_b32 v88, 16, v64
v_and_b32 v89, s38, v64
v_lshlrev_b32 v90, 16, v65
v_and_b32 v91, s38, v65
v_lshlrev_b32 v92, 16, v66
v_and_b32 v93, s38, v66
v_lshlrev_b32 v94, 16, v67
v_and_b32 v95, s38, v67
v_pk_add_f32 v[72:73], v[72:73], v[88:89]
v_max_f32 v80, v80, v88
v_max_f32 v81, v81, v89
v_pk_add_f32 v[74:75], v[74:75], v[90:91]
v_max_f32 v82, v82, v90
v_max_f32 v83, v83, v91
v_pk_add_f32 v[76:77], v[76:77], v[92:93]
v_max_f32 v84, v84, v92
v_max_f32 v85, v85, v93
v_pk_add_f32 v[78:79], v[78:79], v[94:95]
v_max_f32 v86, v86, v94
v_max_f32 v87, v87, v95
s_waitcnt lgkmcnt(0)
v_readfirstlane_b32 s52, v136
v_mov_b32 v95, v136
v_permlane32_swap_b32 v72, v76
v_permlane32_swap_b32 v73, v77
v_permlane32_swap_b32 v74, v78
v_permlane32_swap_b32 v75, v79
v_permlane32_swap_b32 v80, v84
v_permlane32_swap_b32 v81, v85
v_permlane32_swap_b32 v82, v86
v_permlane32_swap_b32 v83, v87
v_pk_add_f32 v[72:73], v[72:73], v[76:77]
v_pk_add_f32 v[74:75], v[74:75], v[78:79]
v_max_f32 v80, v80, v84
v_max_f32 v81, v81, v85
v_max_f32 v82, v82, v86
v_max_f32 v83, v83, v87
v_permlane16_swap_b32 v72, v74
v_permlane16_swap_b32 v73, v75
v_permlane16_swap_b32 v80, v82
v_permlane16_swap_b32 v81, v83
v_pk_add_f32 v[88:89], v[72:73], v[74:75]
v_max_f32 v90, v80, v82
v_max_f32 v91, v81, v83
s_cmp_eq_u32 s52, 0
s_cselect_b32 s41, 63, 3
s_waitcnt vmcnt(0)
v_permlane32_swap_b32 v68, v70
v_permlane32_swap_b32 v69, v71
s_nop 1
v_permlane16_swap_b32 v68, v69
v_permlane16_swap_b32 v70, v71
v_lshlrev_b32 v72, 16, v68
v_and_b32 v73, s38, v68
v_lshlrev_b32 v74, 16, v69
v_and_b32 v75, s38, v69
v_lshlrev_b32 v76, 16, v70
v_and_b32 v77, s38, v70
v_lshlrev_b32 v78, 16, v71
v_and_b32 v79, s38, v71
v_max3_f32 v90, v90, v72, v74
v_max3_f32 v91, v91, v73, v75
v_pk_add_f32 v[72:73], v[72:73], v[74:75]
v_pk_add_f32 v[80:81], v[76:77], v[78:79]
v_max3_f32 v90, v90, v76, v78
v_pk_add_f32 v[88:89], v[88:89], v[72:73]
v_max3_f32 v91, v91, v77, v79
v_pk_add_f32 v[88:89], v[88:89], v[80:81]
v_max_f32_dpp v90, v90, v90 row_ror:8 row_mask:0xf bank_mask:0xf
v_max_f32_dpp v91, v91, v91 row_ror:8 row_mask:0xf bank_mask:0xf
v_add_f32_dpp v88, v88, v88 row_ror:8 row_mask:0xf bank_mask:0xf
v_add_f32_dpp v89, v89, v89 row_ror:8 row_mask:0xf bank_mask:0xf
ds_write_b128 v133, v[88:91]
s_mov_b64 exec, 1
ds_add_rtn_u32 v6, v4, v5
s_mov_b64 exec, -1
ds_read_b128 v[72:75], v134 offset:0
ds_read_b128 v[76:79], v134 offset:1536
ds_read_b128 v[80:83], v134 offset:3072
ds_read_b128 v[84:87], v134 offset:4608
s_waitcnt lgkmcnt(0)
v_readfirstlane_b32 s40, v6
v_max3_f32 v74, v74, v78, v82
v_max3_f32 v75, v75, v79, v83
v_pk_add_f32 v[72:73], v[72:73], v[76:77]
v_pk_add_f32 v[80:81], v[80:81], v[84:85]
v_max_f32 v74, v74, v86
v_max_f32 v75, v75, v87
s_cmp_lg_u32 s40, s41
v_pk_add_f32 v[92:93], v[72:73], v[80:81]
v_perm_b32 v94, v75, v74, s55
s_cbranch_scc1 L_notfast
L_pub:
buffer_store_dwordx4 v[92:95], v140, s[24:27], s61 offen sc1
v_mov_b32 v2, 52628
ds_write_b32 v2, v95
L_pubdone:
v_permlane16_swap_b32 v68, v69
v_permlane16_swap_b32 v70, v71
s_lshr_b32 s40, s36, 1
s_cmp_eq_u32 s40, 2
s_cbranch_scc1 L_service
L_noservice:
v_permlane32_swap_b32 v68, v70
v_permlane32_swap_b32 v69, v71
s_mov_b32 s4, 1
s_add_u32 s40, s100, 12288
s_cmp_lg_u32 s36, 3
s_waitcnt lgkmcnt(0)
s_barrier
s_cbranch_scc1 L_nohead
s_atomic_add s4, s[24:25], s40 glc
L_nohead:
buffer_load_dwordx4 v120, s[32:35], s59 offen lds
s_add_u32 m0, s58, 1024
s_nop 0
buffer_load_dwordx4 v121, s[32:35], s59 offen lds
s_add_u32 m0, s58, 2048
s_nop 0
buffer_load_dwordx4 v122, s[32:35], s59 offen lds
s_cmp_eq_u32 s36, 3
s_cbranch_scc1 L_ticket
L_noticket:
v_mov_b32 v2, 52624
v_lshrrev_b32 v4, 4, v132
v_bfe_u32 v5, v132, 2, 2
v_lshl_add_u32 v5, v4, 3, v5
v_and_b32 v6, 3, v132
v_lshlrev_b32 v6, 3, v6
v_bfe_u32 v7, v132, 3, 2
v_xor_b32 v7, s36, v7
v_lshl_add_u32 v7, v7, 5, v6
s_movk_i32 s40, 384
v_mad_u32_u24 v7, v5, s40, v7
s_sub_u32 s41, s36, 4
s_lshr_b32 s58, s41, 1
s_lshl_b32 s58, s58, 14
s_and_b32 s40, s41, 1
s_lshl_b32 s40, s40, 12
s_add_u32 s58, s58, s40
s_mov_b32 s42, 4000000
s_mov_b32 s61, 0
s_mov_b32 s53, 0
L_role:
ds_read_b96 v[88:90], v2
s_sub_u32 s42, s42, 1
s_cbranch_scc1 L_roleok
s_waitcnt lgkmcnt(0)
v_readfirstlane_b32 s61, v88
v_readfirstlane_b32 s52, v89
v_readfirstlane_b32 s53, v90
s_cmp_eq_u32 s61, 0
s_cbranch_scc1 L_role
L_roleok:
s_sub_u32 s61, s61, 1
s_cmp_lt_u32 s36, 4
s_cselect_b32 s40, 64, s61
s_cmp_ge_u32 s40, 12
s_cbranch_scc1 L_nofirst
s_lshl_b32 s40, s61, 16
s_add_u32 s58, s58, s40
s_add_u32 s58, s58, s53
buffer_load_dwordx4 v[72:75], v139, s[24:27], s58 offen offset:0 sc1
buffer_load_dwordx4 v[76:79], v139, s[24:27], s58 offen offset:1024 sc1
buffer_load_dwordx4 v[80:83], v139, s[24:27], s58 offen offset:2048 sc1
buffer_load_dwordx4 v[84:87], v139, s[24:27], s58 offen offset:3072 sc1
v_mul_u32_u24 v141, 192, v5
v_add_u32 v141, v141, v6
s_lshl_b32 s41, s41, 8
v_lshlrev_b32 v3, 2, v132
v_add_u32 v140, s41, v3
v_and_b32 v2, 1, v4
v_lshlrev_b32 v2, 6, v2
v_and_b32 v5, 15, v132
v_lshl_add_u32 v2, v5, 2, v2
v_lshrrev_b32 v5, 5, v132
v_lshl_add_u32 v2, v5, 1, v2
v_bfe_u32 v5, v132, 2, 1
v_lshlrev_b32 v5, 6, v5
v_lshl_add_u32 v133, v4, 4, v5
v_mov_b32 v134, 52620
v_mov_b32 v136, 1
v_mov_b32 v163, s52
s_lshl_b32 s61, s61, 10
s_add_u32 s59, s61, s100
s_mov_b32 s41, 0x37800000
s_mov_b32 s42, 1000000
s_waitcnt vmcnt(4)
s_barrier
ds_read_b64_tr_b16 v[96:97], v141 offset:36864
ds_read_b64_tr_b16 v[98:99], v141 offset:37632
ds_read_b64_tr_b16 v[100:101], v141 offset:36896
ds_read_b64_tr_b16 v[102:103], v141 offset:37664
ds_read_b64_tr_b16 v[104:105], v141 offset:36928
ds_read_b64_tr_b16 v[106:107], v141 offset:37696
ds_read_b64_tr_b16 v[108:109], v141 offset:36960
ds_read_b64_tr_b16 v[110:111], v141 offset:37728
ds_read_b64_tr_b16 v[112:113], v141 offset:36992
ds_read_b64_tr_b16 v[114:115], v141 offset:37760
ds_read_b64_tr_b16 v[116:117], v141 offset:37024
ds_read_b64_tr_b16 v[118:119], v141 offset:37792
s_branch L_pwait
L_pagain:
s_sub_u32 s42, s42, 1
s_cbranch_scc1 L_pdone
v_cmp_ne_u32 s[92:93], s52, v75
v_cmp_ne_u32 s[94:95], s52, v79
v_cmp_ne_u32 s[96:97], s52, v83
v_cmp_ne_u32 s[98:99], s52, v87
s_wqm_b64 exec, s[92:93]
s_cbranch_execz L_pskip0
buffer_load_dwordx4 v[72:75], v139, s[24:27], s58 offen offset:0 sc1
L_pskip0:
s_wqm_b64 exec, s[94:95]
s_cbranch_execz L_pskip1
buffer_load_dwordx4 v[76:79], v139, s[24:27], s58 offen offset:1024 sc1
L_pskip1:
s_wqm_b64 exec, s[96:97]
s_cbranch_execz L_pskip2
buffer_load_dwordx4 v[80:83], v139, s[24:27], s58 offen offset:2048 sc1
L_pskip2:
s_wqm_b64 exec, s[98:99]
s_cbranch_execz L_pskip3
buffer_load_dwordx4 v[84:87], v139, s[24:27], s58 offen offset:3072 sc1
L_pskip3:
s_mov_b64 exec, -1
L_pwait:
s_waitcnt vmcnt(0)
v_bitop3_b32 v4, s52, v75, v79 bitop3:0x7e
v_bitop3_b32 v5, s52, v83, v87 bitop3:0x7e
v_pk_add_f32 v[88:89], v[72:73], v[76:77]
v_or_b32 v4, v4, v5
v_pk_add_f32 v[92:93], v[80:81], v[84:85]
v_cmp_ne_u32 vcc, 0, v4
v_max3_f32 v91, v74, v78, v82
v_pk_add_f32 v[88:89], v[88:89], v[92:93]
s_cbranch_vccnz L_pagain
L_pdone:
v_lshlrev_b32 v92, 16, v74
v_lshlrev_b32 v93, 16, v78
v_lshlrev_b32 v94, 16, v82
v_lshlrev_b32 v95, 16, v86
v_permlane32_swap_b32 v88, v89
v_max_f32 v91, v91, v86
v_max3_f32 v90, v92, v93, v94
v_and_b32 v91, s38, v91
v_max_f32 v90, v90, v95
v_add_f32 v88, v88, v89
s_nop 0
v_permlane32_swap_b32 v90, v91
v_max_f32 v90, v90, v91
s_nop 1
v_permlane16_swap_b32 v88, v90
v_add_f32 v89, v88, v90
v_max_f32 v91, v88, v90
v_cndmask_b32 v89, v89, v91, s[48:49]
ds_write_b32 v140, v89 offset:49152
s_mov_b64 exec, 1
ds_add_rtn_u32 v5, v134, v136
s_mov_b64 exec, -1
ds_read2st64_b32 v[72:73], v3 offset0:192 offset1:193
ds_read2st64_b32 v[74:75], v3 offset0:194 offset1:195
ds_read2st64_b32 v[76:77], v3 offset0:196 offset1:197
ds_read2st64_b32 v[78:79], v3 offset0:198 offset1:199
s_waitcnt lgkmcnt(0)
v_readfirstlane_b32 s40, v5
v_max3_f32 v88, v72, v73, v74
v_max3_f32 v89, v75, v76, v77
v_pk_add_f32 v[72:73], v[72:73], v[74:75]
v_pk_add_f32 v[76:77], v[76:77], v[78:79]
s_cmp_lg_u32 s40, 7
v_max3_f32 v88, v88, v78, v79
v_pk_add_f32 v[72:73], v[72:73], v[76:77]
s_cbranch_scc1 L_reddone
v_max_f32 v88, v88, v89
v_add_f32 v72, v72, v73
v_mul_f32 v72, s41, v72
v_cndmask_b32 v72, v72, v88, s[48:49]
v_cvt_pk_bf16_f32 v72, v72, v72
ds_write_b16 v2, v72 offset:51200
ds_read_b128 v[88:91], v133 offset:51200
s_waitcnt lgkmcnt(0)
v_mfma_f32_16x16x32_bf16 v[72:75], v[88:91], v[96:99], 0
v_mfma_f32_16x16x32_bf16 v[76:79], v[88:91], v[100:103], 0
v_mfma_f32_16x16x32_bf16 v[80:83], v[88:91], v[104:107], 0
v_mfma_f32_16x16x32_bf16 v[84:87], v[88:91], v[108:111], 0
v_mfma_f32_16x16x32_bf16 v[92:95], v[88:91], v[112:115], 0
v_mfma_f32_16x16x32_bf16 v[96:99], v[88:91], v[116:119], 0
s_nop 3
v_cndmask_b32 v160, v72, v76, s[46:47]
s_nop 0
v_cndmask_b32 v161, v80, v84, s[46:47]
s_add_u32 s101, s61, 917504
v_cndmask_b32 v162, v92, v96, s[46:47]
buffer_store_dwordx4 v[160:163], v139, s[24:27], s59 offen
s_mov_b32 s11, s59
L_reddone:
s_barrier
s_mov_b32 s61, 64
s_branch L_notred
L_nofirst:
s_waitcnt vmcnt(0)
s_barrier
L_notred:
ds_read_b64_tr_b16 v[120:121], v7 offset:0
ds_read_b64_tr_b16 v[122:123], v7 offset:1536
ds_read_b64_tr_b16 v[124:125], v7 offset:12288
ds_read_b64_tr_b16 v[126:127], v7 offset:13824
ds_read_b64_tr_b16 v[128:129], v7 offset:24576
ds_read_b64_tr_b16 v[130:131], v7 offset:26112
v_lshlrev_b32 v96, 16, v8
v_and_b32 v97, s38, v8
v_lshlrev_b32 v98, 16, v9
v_and_b32 v99, s38, v9
v_lshlrev_b32 v100, 16, v10
v_and_b32 v101, s38, v10
v_lshlrev_b32 v102, 16, v11
v_and_b32 v103, s38, v11
s_mov_b32 s55, 0xbfb8aa3b
s_mov_b32 s37, s39
s_cmp_ge_u32 s36, 4
s_cbranch_scc1 L_b4
v_and_b32 v5, 15, v132
v_lshlrev_b32 v2, 10, v4
v_lshl_add_u32 v2, v5, 4, v2
s_lshl_b32 s40, s36, 8
v_add_u32 v2, s40, v2
s_mov_b32 s58, s100
s_add_u32 s59, s58, 4096
s_add_u32 s60, s58, 8192
s_and_b32 s40, s36, 1
s_mul_i32 s40, s40, 192
s_lshr_b32 s41, s36, 1
s_lshl_b32 s41, s41, 5
s_add_u32 s40, s40, s41
v_lshl_add_u32 v3, v4, 6, s40
v_lshl_add_u32 v3, v5, 1, v3
v_mov_b32 v6, 384
v_cmp_eq_u32 vcc, 3, v4
s_mov_b32 s42, 1000000
s_nop 0
v_cndmask_b32 v3, v3, v6, vcc
s_cmp_ge_u32 s61, 12
s_cbranch_scc1 L_hfirst
s_barrier
L_hfirst:
buffer_load_dwordx4 v[72:75], v2, s[24:27], s58 offen sc1
buffer_load_dwordx4 v[76:79], v2, s[24:27], s59 offen sc1
buffer_load_dwordx4 v[80:83], v2, s[24:27], s60 offen sc1
s_branch L_hwait
L_hagain:
s_sub_u32 s42, s42, 1
s_cbranch_scc1 L_hdone
s_cmp_lt_u32 s42, 999700
s_cbranch_scc1 L_hswitch
L_hload:
v_cmp_ne_u32 s[92:93], s52, v75
v_cmp_ne_u32 s[94:95], s52, v79
v_cmp_ne_u32 s[96:97], s52, v83
s_wqm_b64 exec, s[92:93]
s_cbranch_execz L_hskip0
buffer_load_dwordx4 v[72:75], v2, s[24:27], s58 offen sc1
L_hskip0:
s_wqm_b64 exec, s[94:95]
s_cbranch_execz L_hskip1
buffer_load_dwordx4 v[76:79], v2, s[24:27], s59 offen sc1
L_hskip1:
s_wqm_b64 exec, s[96:97]
s_cbranch_execz L_hskip2
buffer_load_dwordx4 v[80:83], v2, s[24:27], s60 offen sc1
L_hskip2:
s_mov_b64 exec, -1
L_hwait:
s_waitcnt vmcnt(0)
v_bitop3_b32 v4, s52, v75, v79 bitop3:0x7e
v_pk_add_f32 v[88:89], v[72:73], v[76:77]
v_pk_add_f32 v[90:91], v[74:75], v[78:79]
v_bitop3_b32 v4, v4, s52, v83 bitop3:0xf6
v_pk_add_f32 v[88:89], v[88:89], v[80:81]
v_pk_add_f32 v[90:91], v[90:91], v[82:83]
v_cmp_ne_u32 vcc, 0, v4
s_cbranch_vccnz L_hagain
L_hdone:
v_permlane32_swap_b32 v88, v90
v_permlane32_swap_b32 v89, v91
v_pk_add_f32 v[88:89], v[88:89], v[90:91]
s_nop 1
v_permlane16_swap_b32 v88, v89
v_add_f32 v88, v88, v89
v_maximum3_f32 v88, v88, 0, 0
v_cvt_pk_bf16_f32 v88, v88, v88
ds_write_b16 v3, v88 offset:51328
L_b4:
s_waitcnt lgkmcnt(0)
s_barrier
ds_read_b128 v[72:75], v137 offset:51328
ds_read_b128 v[76:79], v137 offset:51392
ds_read_b128 v[80:83], v137 offset:51456
s_sub_u32 s41, s20, s16
s_and_b32 s41, s41, 8191
s_sub_u32 s41, s41, 3072
s_cmp_le_u32 s41, 2048
s_cselect_b64 vcc, -1, 0
s_waitcnt lgkmcnt(2)
v_mfma_f32_16x16x32_bf16 v[88:91], v[72:75], v[120:123], 0
s_waitcnt lgkmcnt(1)
v_mfma_f32_16x16x32_bf16 v[88:91], v[76:79], v[124:127], v[88:91]
s_waitcnt lgkmcnt(0)
v_mfma_f32_16x16x32_bf16 v[88:91], v[80:83], v[128:131], v[88:91]
s_nop 7
v_cvt_pk_bf16_f32 v5, 0, v88
v_cvt_pk_bf16_f32 v6, 0, v89
v_add_f32 v5, v5, v6
v_cvt_pk_bf16_f32 v5, 0, v5
v_mul_f32 v5, s55, v5
v_exp_f32 v5, v5
s_nop 0
v_add_f32 v5, 1.0, v5
v_rcp_f32 v5, v5
s_nop 0
v_cvt_pk_bf16_f32 v5, 0, v5
ds_write_b32 v138, v5
s_waitcnt lgkmcnt(0)
s_barrier
ds_read_b128 v[72:75], v135
ds_read_b128 v[76:79], v135 offset:16
s_cmp_lg_u32 s101, 0
s_cbranch_scc1 L_gcopy
L_gdone:
s_waitcnt lgkmcnt(0)
v_pk_mul_f32 v[96:97], v[96:97], v[72:73]
v_pk_mul_f32 v[98:99], v[98:99], v[74:75]
v_pk_mul_f32 v[100:101], v[100:101], v[76:77]
v_pk_mul_f32 v[102:103], v[102:103], v[78:79]
v_cvt_pk_bf16_f32 v8, v96, v97
v_cvt_pk_bf16_f32 v9, v98, v99
v_cvt_pk_bf16_f32 v10, v100, v101
v_cvt_pk_bf16_f32 v11, v102, v103
buffer_store_dwordx4 v[8:11], v144, s[20:23], s37 offen sc1
s_addk_i32 s37, 6144
v_lshlrev_b32 v80, 16, v12
v_and_b32 v81, s38, v12
v_lshlrev_b32 v82, 16, v13
v_and_b32 v83, s38, v13
v_lshlrev_b32 v84, 16, v14
v_and_b32 v85, s38, v14
v_lshlrev_b32 v86, 16, v15
v_and_b32 v87, s38, v15
v_pk_mul_f32 v[80:81], v[80:81], v[72:73]
v_pk_mul_f32 v[82:83], v[82:83], v[74:75]
v_pk_mul_f32 v[84:85], v[84:85], v[76:77]
v_pk_mul_f32 v[86:87], v[86:87], v[78:79]
v_cvt_pk_bf16_f32 v12, v80, v81
v_cvt_pk_bf16_f32 v13, v82, v83
v_cvt_pk_bf16_f32 v14, v84, v85
v_cvt_pk_bf16_f32 v15, v86, v87
s_cbranch_vccnz L_c1
s_waitcnt vmcnt(0)
L_c1:
buffer_store_dwordx4 v[12:15], v145, s[20:23], s37 offen sc1
s_addk_i32 s37, 6144
v_lshlrev_b32 v80, 16, v16
v_and_b32 v81, s38, v16
v_lshlrev_b32 v82, 16, v17
v_and_b32 v83, s38, v17
v_lshlrev_b32 v84, 16, v18
v_and_b32 v85, s38, v18
v_lshlrev_b32 v86, 16, v19
v_and_b32 v87, s38, v19
v_pk_mul_f32 v[80:81], v[80:81], v[72:73]
v_pk_mul_f32 v[82:83], v[82:83], v[74:75]
v_pk_mul_f32 v[84:85], v[84:85], v[76:77]
v_pk_mul_f32 v[86:87], v[86:87], v[78:79]
v_cvt_pk_bf16_f32 v16, v80, v81
v_cvt_pk_bf16_f32 v17, v82, v83
v_cvt_pk_bf16_f32 v18, v84, v85
v_cvt_pk_bf16_f32 v19, v86, v87
s_waitcnt vmcnt(1)
s_cbranch_vccnz L_c2
s_waitcnt vmcnt(0)
L_c2:
buffer_store_dwordx4 v[16:19], v146, s[20:23], s37 offen sc1
s_addk_i32 s37, 6144
v_lshlrev_b32 v80, 16, v20
v_and_b32 v81, s38, v20
v_lshlrev_b32 v82, 16, v21
v_and_b32 v83, s38, v21
v_lshlrev_b32 v84, 16, v22
v_and_b32 v85, s38, v22
v_lshlrev_b32 v86, 16, v23
v_and_b32 v87, s38, v23
v_pk_mul_f32 v[80:81], v[80:81], v[72:73]
v_pk_mul_f32 v[82:83], v[82:83], v[74:75]
v_pk_mul_f32 v[84:85], v[84:85], v[76:77]
v_pk_mul_f32 v[86:87], v[86:87], v[78:79]
v_cvt_pk_bf16_f32 v20, v80, v81
v_cvt_pk_bf16_f32 v21, v82, v83
v_cvt_pk_bf16_f32 v22, v84, v85
v_cvt_pk_bf16_f32 v23, v86, v87
s_waitcnt vmcnt(1)
s_cbranch_vccnz L_c3
s_waitcnt vmcnt(0)
L_c3:
buffer_store_dwordx4 v[20:23], v147, s[20:23], s37 offen sc1
s_add_u32 s37, s37, s54
v_lshlrev_b32 v80, 16, v24
v_and_b32 v81, s38, v24
v_lshlrev_b32 v82, 16, v25
v_and_b32 v83, s38, v25
v_lshlrev_b32 v84, 16, v26
v_and_b32 v85, s38, v26
v_lshlrev_b32 v86, 16, v27
v_and_b32 v87, s38, v27
v_pk_mul_f32 v[80:81], v[80:81], v[72:73]
v_pk_mul_f32 v[82:83], v[82:83], v[74:75]
v_pk_mul_f32 v[84:85], v[84:85], v[76:77]
v_pk_mul_f32 v[86:87], v[86:87], v[78:79]
v_cvt_pk_bf16_f32 v24, v80, v81
v_cvt_pk_bf16_f32 v25, v82, v83
v_cvt_pk_bf16_f32 v26, v84, v85
v_cvt_pk_bf16_f32 v27, v86, v87
s_waitcnt vmcnt(1)
s_cbranch_vccnz L_c4
s_waitcnt vmcnt(0)
L_c4:
buffer_store_dwordx4 v[24:27], v148, s[20:23], s37 offen sc1
s_addk_i32 s37, 6144
v_lshlrev_b32 v80, 16, v28
v_and_b32 v81, s38, v28
v_lshlrev_b32 v82, 16, v29
v_and_b32 v83, s38, v29
v_lshlrev_b32 v84, 16, v30
v_and_b32 v85, s38, v30
v_lshlrev_b32 v86, 16, v31
v_and_b32 v87, s38, v31
v_pk_mul_f32 v[80:81], v[80:81], v[72:73]
v_pk_mul_f32 v[82:83], v[82:83], v[74:75]
v_pk_mul_f32 v[84:85], v[84:85], v[76:77]
v_pk_mul_f32 v[86:87], v[86:87], v[78:79]
v_cvt_pk_bf16_f32 v28, v80, v81
v_cvt_pk_bf16_f32 v29, v82, v83
v_cvt_pk_bf16_f32 v30, v84, v85
v_cvt_pk_bf16_f32 v31, v86, v87
s_waitcnt vmcnt(1)
s_cbranch_vccnz L_c5
s_waitcnt vmcnt(0)
L_c5:
buffer_store_dwordx4 v[28:31], v149, s[20:23], s37 offen sc1
s_addk_i32 s37, 6144
v_lshlrev_b32 v80, 16, v32
v_and_b32 v81, s38, v32
v_lshlrev_b32 v82, 16, v33
v_and_b32 v83, s38, v33
v_lshlrev_b32 v84, 16, v34
v_and_b32 v85, s38, v34
v_lshlrev_b32 v86, 16, v35
v_and_b32 v87, s38, v35
v_pk_mul_f32 v[80:81], v[80:81], v[72:73]
v_pk_mul_f32 v[82:83], v[82:83], v[74:75]
v_pk_mul_f32 v[84:85], v[84:85], v[76:77]
v_pk_mul_f32 v[86:87], v[86:87], v[78:79]
v_cvt_pk_bf16_f32 v32, v80, v81
v_cvt_pk_bf16_f32 v33, v82, v83
v_cvt_pk_bf16_f32 v34, v84, v85
v_cvt_pk_bf16_f32 v35, v86, v87
s_waitcnt vmcnt(1)
s_cbranch_vccnz L_c6
s_waitcnt vmcnt(0)
L_c6:
buffer_store_dwordx4 v[32:35], v150, s[20:23], s37 offen sc1
s_addk_i32 s37, 6144
v_lshlrev_b32 v80, 16, v36
v_and_b32 v81, s38, v36
v_lshlrev_b32 v82, 16, v37
v_and_b32 v83, s38, v37
v_lshlrev_b32 v84, 16, v38
v_and_b32 v85, s38, v38
v_lshlrev_b32 v86, 16, v39
v_and_b32 v87, s38, v39
v_pk_mul_f32 v[80:81], v[80:81], v[72:73]
v_pk_mul_f32 v[82:83], v[82:83], v[74:75]
v_pk_mul_f32 v[84:85], v[84:85], v[76:77]
v_pk_mul_f32 v[86:87], v[86:87], v[78:79]
v_cvt_pk_bf16_f32 v36, v80, v81
v_cvt_pk_bf16_f32 v37, v82, v83
v_cvt_pk_bf16_f32 v38, v84, v85
v_cvt_pk_bf16_f32 v39, v86, v87
s_waitcnt vmcnt(1)
s_cbranch_vccnz L_c7
s_waitcnt vmcnt(0)
L_c7:
buffer_store_dwordx4 v[36:39], v151, s[20:23], s37 offen sc1
s_add_u32 s37, s37, s54
v_lshlrev_b32 v80, 16, v40
v_and_b32 v81, s38, v40
v_lshlrev_b32 v82, 16, v41
v_and_b32 v83, s38, v41
v_lshlrev_b32 v84, 16, v42
v_and_b32 v85, s38, v42
v_lshlrev_b32 v86, 16, v43
v_and_b32 v87, s38, v43
v_pk_mul_f32 v[80:81], v[80:81], v[72:73]
v_pk_mul_f32 v[82:83], v[82:83], v[74:75]
v_pk_mul_f32 v[84:85], v[84:85], v[76:77]
v_pk_mul_f32 v[86:87], v[86:87], v[78:79]
v_cvt_pk_bf16_f32 v40, v80, v81
v_cvt_pk_bf16_f32 v41, v82, v83
v_cvt_pk_bf16_f32 v42, v84, v85
v_cvt_pk_bf16_f32 v43, v86, v87
s_waitcnt vmcnt(1)
s_cbranch_vccnz L_c8
s_waitcnt vmcnt(0)
L_c8:
buffer_store_dwordx4 v[40:43], v152, s[20:23], s37 offen sc1
s_addk_i32 s37, 6144
v_lshlrev_b32 v80, 16, v44
v_and_b32 v81, s38, v44
v_lshlrev_b32 v82, 16, v45
v_and_b32 v83, s38, v45
v_lshlrev_b32 v84, 16, v46
v_and_b32 v85, s38, v46
v_lshlrev_b32 v86, 16, v47
v_and_b32 v87, s38, v47
v_pk_mul_f32 v[80:81], v[80:81], v[72:73]
v_pk_mul_f32 v[82:83], v[82:83], v[74:75]
v_pk_mul_f32 v[84:85], v[84:85], v[76:77]
v_pk_mul_f32 v[86:87], v[86:87], v[78:79]
v_cvt_pk_bf16_f32 v44, v80, v81
v_cvt_pk_bf16_f32 v45, v82, v83
v_cvt_pk_bf16_f32 v46, v84, v85
v_cvt_pk_bf16_f32 v47, v86, v87
s_waitcnt vmcnt(1)
s_cbranch_vccnz L_c9
s_waitcnt vmcnt(0)
L_c9:
buffer_store_dwordx4 v[44:47], v153, s[20:23], s37 offen sc1
s_addk_i32 s37, 6144
v_lshlrev_b32 v80, 16, v48
v_and_b32 v81, s38, v48
v_lshlrev_b32 v82, 16, v49
v_and_b32 v83, s38, v49
v_lshlrev_b32 v84, 16, v50
v_and_b32 v85, s38, v50
v_lshlrev_b32 v86, 16, v51
v_and_b32 v87, s38, v51
v_pk_mul_f32 v[80:81], v[80:81], v[72:73]
v_pk_mul_f32 v[82:83], v[82:83], v[74:75]
v_pk_mul_f32 v[84:85], v[84:85], v[76:77]
v_pk_mul_f32 v[86:87], v[86:87], v[78:79]
v_cvt_pk_bf16_f32 v48, v80, v81
v_cvt_pk_bf16_f32 v49, v82, v83
v_cvt_pk_bf16_f32 v50, v84, v85
v_cvt_pk_bf16_f32 v51, v86, v87
s_waitcnt vmcnt(1)
s_cbranch_vccnz L_c10
s_waitcnt vmcnt(0)
L_c10:
buffer_store_dwordx4 v[48:51], v154, s[20:23], s37 offen sc1
s_addk_i32 s37, 6144
v_lshlrev_b32 v80, 16, v52
v_and_b32 v81, s38, v52
v_lshlrev_b32 v82, 16, v53
v_and_b32 v83, s38, v53
v_lshlrev_b32 v84, 16, v54
v_and_b32 v85, s38, v54
v_lshlrev_b32 v86, 16, v55
v_and_b32 v87, s38, v55
v_pk_mul_f32 v[80:81], v[80:81], v[72:73]
v_pk_mul_f32 v[82:83], v[82:83], v[74:75]
v_pk_mul_f32 v[84:85], v[84:85], v[76:77]
v_pk_mul_f32 v[86:87], v[86:87], v[78:79]
v_cvt_pk_bf16_f32 v52, v80, v81
v_cvt_pk_bf16_f32 v53, v82, v83
v_cvt_pk_bf16_f32 v54, v84, v85
v_cvt_pk_bf16_f32 v55, v86, v87
s_waitcnt vmcnt(1)
s_cbranch_vccnz L_c11
s_waitcnt vmcnt(0)
L_c11:
buffer_store_dwordx4 v[52:55], v155, s[20:23], s37 offen sc1
s_add_u32 s37, s37, s54
v_lshlrev_b32 v80, 16, v56
v_and_b32 v81, s38, v56
v_lshlrev_b32 v82, 16, v57
v_and_b32 v83, s38, v57
v_lshlrev_b32 v84, 16, v58
v_and_b32 v85, s38, v58
v_lshlrev_b32 v86, 16, v59
v_and_b32 v87, s38, v59
v_pk_mul_f32 v[80:81], v[80:81], v[72:73]
v_pk_mul_f32 v[82:83], v[82:83], v[74:75]
v_pk_mul_f32 v[84:85], v[84:85], v[76:77]
v_pk_mul_f32 v[86:87], v[86:87], v[78:79]
v_cvt_pk_bf16_f32 v56, v80, v81
v_cvt_pk_bf16_f32 v57, v82, v83
v_cvt_pk_bf16_f32 v58, v84, v85
v_cvt_pk_bf16_f32 v59, v86, v87
s_waitcnt vmcnt(1)
s_cbranch_vccnz L_c12
s_waitcnt vmcnt(0)
L_c12:
buffer_store_dwordx4 v[56:59], v156, s[20:23], s37 offen sc1
s_addk_i32 s37, 6144
v_lshlrev_b32 v80, 16, v60
v_and_b32 v81, s38, v60
v_lshlrev_b32 v82, 16, v61
v_and_b32 v83, s38, v61
v_lshlrev_b32 v84, 16, v62
v_and_b32 v85, s38, v62
v_lshlrev_b32 v86, 16, v63
v_and_b32 v87, s38, v63
v_pk_mul_f32 v[80:81], v[80:81], v[72:73]
v_pk_mul_f32 v[82:83], v[82:83], v[74:75]
v_pk_mul_f32 v[84:85], v[84:85], v[76:77]
v_pk_mul_f32 v[86:87], v[86:87], v[78:79]
v_cvt_pk_bf16_f32 v60, v80, v81
v_cvt_pk_bf16_f32 v61, v82, v83
v_cvt_pk_bf16_f32 v62, v84, v85
v_cvt_pk_bf16_f32 v63, v86, v87
s_waitcnt vmcnt(1)
s_cbranch_vccnz L_c13
s_waitcnt vmcnt(0)
L_c13:
buffer_store_dwordx4 v[60:63], v157, s[20:23], s37 offen sc1
s_addk_i32 s37, 6144
v_lshlrev_b32 v80, 16, v64
v_and_b32 v81, s38, v64
v_lshlrev_b32 v82, 16, v65
v_and_b32 v83, s38, v65
v_lshlrev_b32 v84, 16, v66
v_and_b32 v85, s38, v66
v_lshlrev_b32 v86, 16, v67
v_and_b32 v87, s38, v67
v_pk_mul_f32 v[80:81], v[80:81], v[72:73]
v_pk_mul_f32 v[82:83], v[82:83], v[74:75]
v_pk_mul_f32 v[84:85], v[84:85], v[76:77]
v_pk_mul_f32 v[86:87], v[86:87], v[78:79]
v_cvt_pk_bf16_f32 v64, v80, v81
v_cvt_pk_bf16_f32 v65, v82, v83
v_cvt_pk_bf16_f32 v66, v84, v85
v_cvt_pk_bf16_f32 v67, v86, v87
buffer_store_dwordx4 v[64:67], v158, s[20:23], s37 offen sc1
s_addk_i32 s37, 6144
v_lshlrev_b32 v80, 16, v68
v_and_b32 v81, s38, v68
v_lshlrev_b32 v82, 16, v69
v_and_b32 v83, s38, v69
v_lshlrev_b32 v84, 16, v70
v_and_b32 v85, s38, v70
v_lshlrev_b32 v86, 16, v71
v_and_b32 v87, s38, v71
v_pk_mul_f32 v[80:81], v[80:81], v[72:73]
v_pk_mul_f32 v[82:83], v[82:83], v[74:75]
v_pk_mul_f32 v[84:85], v[84:85], v[76:77]
v_pk_mul_f32 v[86:87], v[86:87], v[78:79]
v_cvt_pk_bf16_f32 v68, v80, v81
v_cvt_pk_bf16_f32 v69, v82, v83
v_cvt_pk_bf16_f32 v70, v84, v85
v_cvt_pk_bf16_f32 v71, v86, v87
buffer_store_dwordx4 v[68:71], v159, s[20:23], s37 offen sc1
s_endpgm
L_notfast:
s_cmp_lg_u32 s40, 3
s_cbranch_scc1 L_pubdone
s_cmp_lg_u32 s52, 0
s_cbranch_scc1 L_tg2_ok
s_mov_b32 s42, 1000000
v_mov_b32 v160, 0
L_tg2_lp:
global_load_dword v161, v160, s[12:13] offset:0 sc1
s_waitcnt vmcnt(0)
v_readfirstlane_b32 s52, v161
s_sub_u32 s42, s42, 1
s_cbranch_scc1 L_tg2_ok
s_cmp_eq_u32 s52, 0
s_cbranch_scc1 L_tg2_lp
L_tg2_ok:
v_mov_b32 v95, s52
s_branch L_pub
L_vote:
s_add_u32 s24, s14, 16383
s_addc_u32 s25, s15, 0
s_and_b32 s24, s24, 0xffffc000
s_lshl_b32 s40, s2, 7
s_add_u32 s40, s40, 951296
s_add_u32 s41, s40, 8192
s_load_dword s3, s[24:25], s40 glc
s_load_dword s3, s[24:25], s41 glc
s_getreg_b32 s63, hwreg(HW_REG_XCC_ID)
s_waitcnt lgkmcnt(0)
s_memtime s[4:5]
s_load_dword s3, s[24:25], s40 glc
s_waitcnt lgkmcnt(0)
s_memtime s[6:7]
s_load_dword s3, s[24:25], s41 glc
s_waitcnt lgkmcnt(0)
s_memtime s[8:9]
s_load_dword s52, s[12:13], 0
s_waitcnt lgkmcnt(0)
s_lshl_b32 s40, s6, 1
s_sub_u32 s40, s40, s4
s_sub_u32 s40, s40, s8
s_cmp_gt_i32 s40, 0
s_cselect_b32 s40, 4, 0
s_xor_b32 s40, s40, s63
s_and_b32 s40, s40, 4
s_xor_b32 s4, s40, s52
s_lshl_b32 s41, s60, 2
s_add_u32 s41, s41, 950272
s_atomic_swap s4, s[24:25], s41
s_branch L_votedone
L_service:
s_cmp_eq_u32 s36, 4
s_cbranch_scc1 L_ready
s_and_b32 s40, s2, 127
s_mul_i32 s40, s40, 576
s_bitcmp1_b32 s2, 7
s_cselect_b64 s[50:51], s[32:33], s[28:29]
s_add_u32 s50, s50, s40
s_addc_u32 s51, s51, 0
s_load_dword s3, s[50:51], 0
s_load_dword s3, s[50:51], 64
s_load_dword s3, s[50:51], 128
s_load_dword s3, s[50:51], 192
s_load_dword s3, s[50:51], 256
s_load_dword s3, s[50:51], 320
s_load_dword s3, s[50:51], 384
s_load_dword s3, s[50:51], 448
s_load_dword s3, s[50:51], 512
s_getpc_b64 s[50:51]
L_pfbase:
s_sub_u32 s50, s50, (L_pfbase-L_noservice)&4294967295
s_subb_u32 s51, s51, 0
s_lshr_b32 s40, s2, 3
s_lshl_b32 s40, s40, 8
s_min_u32 s40, s40, (L_end-L_noservice-192)&4294967295
s_add_u32 s50, s50, s40
s_addc_u32 s51, s51, 0
s_load_dword s3, s[50:51], 0
s_load_dword s3, s[50:51], 64
s_load_dword s3, s[50:51], 128
s_load_dword s3, s[50:51], 192
s_branch L_noservice
L_ready:
s_load_dword s40, s[12:13], 0x80
s_load_dword s52, s[12:13], 0
s_load_dwordx8 s[92:99], s[24:25], 950272
s_waitcnt lgkmcnt(0)
s_xor_b32 s41, s52, 4
s_mov_b32 s53, 0
s_cmp_eq_u32 s92, s41
s_addc_u32 s53, s53, 0
s_cmp_eq_u32 s92, s52
s_subb_u32 s53, s53, 0
s_cmp_eq_u32 s93, s41
s_addc_u32 s53, s53, 0
s_cmp_eq_u32 s93, s52
s_subb_u32 s53, s53, 0
s_cmp_eq_u32 s94, s41
s_addc_u32 s53, s53, 0
s_cmp_eq_u32 s94, s52
s_subb_u32 s53, s53, 0
s_cmp_eq_u32 s95, s41
s_addc_u32 s53, s53, 0
s_cmp_eq_u32 s95, s52
s_subb_u32 s53, s53, 0
s_cmp_eq_u32 s96, s41
s_addc_u32 s53, s53, 0
s_cmp_eq_u32 s96, s52
s_subb_u32 s53, s53, 0
s_cmp_eq_u32 s97, s41
s_addc_u32 s53, s53, 0
s_cmp_eq_u32 s97, s52
s_subb_u32 s53, s53, 0
s_cmp_eq_u32 s98, s41
s_addc_u32 s53, s53, 0
s_cmp_eq_u32 s98, s52
s_subb_u32 s53, s53, 0
s_cmp_eq_u32 s99, s41
s_addc_u32 s53, s53, 0
s_cmp_eq_u32 s99, s52
s_subb_u32 s53, s53, 0
s_load_dwordx8 s[92:99], s[24:25], 950304
s_waitcnt lgkmcnt(0)
s_cmp_eq_u32 s92, s41
s_addc_u32 s53, s53, 0
s_cmp_eq_u32 s92, s52
s_subb_u32 s53, s53, 0
s_cmp_eq_u32 s93, s41
s_addc_u32 s53, s53, 0
s_cmp_eq_u32 s93, s52
s_subb_u32 s53, s53, 0
s_cmp_eq_u32 s94, s41
s_addc_u32 s53, s53, 0
s_cmp_eq_u32 s94, s52
s_subb_u32 s53, s53, 0
s_cmp_eq_u32 s95, s41
s_addc_u32 s53, s53, 0
s_cmp_eq_u32 s95, s52
s_subb_u32 s53, s53, 0
s_cmp_eq_u32 s96, s41
s_addc_u32 s53, s53, 0
s_cmp_eq_u32 s96, s52
s_subb_u32 s53, s53, 0
s_cmp_eq_u32 s97, s41
s_addc_u32 s53, s53, 0
s_cmp_eq_u32 s97, s52
s_subb_u32 s53, s53, 0
s_cmp_eq_u32 s98, s41
s_addc_u32 s53, s53, 0
s_cmp_eq_u32 s98, s52
s_subb_u32 s53, s53, 0
s_cmp_eq_u32 s99, s41
s_addc_u32 s53, s53, 0
s_cmp_eq_u32 s99, s52
s_subb_u32 s53, s53, 0
s_cmp_gt_i32 s53, 0
s_cselect_b32 s53, 4, 0
s_xor_b32 s53, s53, s63
s_and_b32 s53, s53, 4
s_lshl_b32 s53, s53, 11
v_mov_b32 v2, 52632
v_mov_b32 v3, s53
ds_write_b32 v2, v3
s_cmp_lg_u32 s40, 0
s_cbranch_scc1 L_rd_ok
s_mov_b32 s42, 1000000
v_mov_b32 v160, 0
L_rd_lp:
global_load_dword v161, v160, s[12:13] offset:128 sc1
s_waitcnt vmcnt(0)
v_readfirstlane_b32 s40, v161
s_sub_u32 s42, s42, 1
s_cbranch_scc1 L_rd_ok
s_cmp_eq_u32 s40, 0
s_cbranch_scc1 L_rd_lp
L_rd_ok:
s_branch L_noservice
L_hswitch:
s_bitcmp1_b32 s42, 0
s_cselect_b32 s58, 917504, s100
s_add_u32 s59, s58, 4096
s_add_u32 s60, s58, 8192
s_branch L_hload
L_gcopy:
buffer_store_dwordx4 v[160:163], v139, s[24:27], s101 offen sc1
buffer_store_dwordx4 v[160:163], v139, s[24:27], s11 offen sc1
s_branch L_gdone
L_ticket:
v_mov_b32 v5, 52624
s_waitcnt lgkmcnt(0)
s_min_u32 s4, s4, 254
s_add_u32 s41, s4, 1
v_mov_b32 v3, s41
ds_write_b32 v5, v3
s_cmp_ge_u32 s4, 12
s_cbranch_scc1 L_noticket
s_mov_b32 m0, 36864
s_mul_i32 s41, s4, 6144
buffer_load_dwordx4 v139, s[28:31], s41 offen offset:0 lds
buffer_load_dwordx4 v139, s[28:31], s41 offen offset:1024 lds
buffer_load_dwordx4 v139, s[28:31], s41 offen offset:2048 lds
s_mov_b32 m0, 39936
s_add_u32 s41, s41, 3072
buffer_load_dwordx4 v139, s[28:31], s41 offen offset:0 lds
buffer_load_dwordx4 v139, s[28:31], s41 offen offset:1024 lds
buffer_load_dwordx4 v139, s[28:31], s41 offen offset:2048 lds
s_branch L_noticket
L_end:
s_endpgm
.section .rodata,"a"
.p2align 6
.amdhsa_kernel standalone__channel_attn_cbam__vision_kernel
  .amdhsa_next_free_vgpr 164
  .amdhsa_next_free_sgpr 102
  .amdhsa_accum_offset 164
  .amdhsa_group_segment_fixed_size 0
  .amdhsa_kernarg_size 48
  .amdhsa_user_sgpr_count 2
  .amdhsa_user_sgpr_kernarg_segment_ptr 1
  .amdhsa_system_sgpr_workgroup_id_x 1
  .amdhsa_float_denorm_mode_32 3
.end_amdhsa_kernel
```
